```python
import torch

def _softmax(x, axis=-1):
    return torch.softmax(x, dim=axis)
def _gelu(x):
    return torch.nn.functional.gelu(x, approximate="tanh")
def _silu(x):
    return torch.nn.functional.silu(x)
def _sigmoid(x):
    return torch.sigmoid(x)
def _layernorm(x, axis=-1, eps=1e-5):
    m = x.mean(dim=axis, keepdim=True)
    v = x.var(dim=axis, keepdim=True, unbiased=False)
    return (x - m) / torch.sqrt(v + eps)
def _scatter_add(tgt, idx, src, axis=0):
    return tgt.clone().index_add_(axis, idx, src)
def _segment_sum(src, seg, n):
    out = torch.zeros((n,) + src.shape[1:], dtype=src.dtype)
    return out.index_add_(0, seg, src)
def _pad(x, pw):
    flat = tuple(v for pair in reversed(pw) for v in pair)
    return torch.nn.functional.pad(x, flat)

kernel_name = 'standalone__consistency_rf_step__diffusion'

def setup_inputs():

    _w = (lambda a: (lambda t: t.to(torch.bfloat16) if t.is_floating_point() else t)(torch.as_tensor(a)))
    B, C, HW = 2, 128, 128
    return {
        "x": _w((lambda *s: torch.randn(*s, dtype=torch.bfloat16) * 0.05)(B, C, HW, HW)),
        "v": _w((lambda *s: torch.randn(*s, dtype=torch.bfloat16) * 0.05)(B, C, HW, HW)),
        "sigma": _w(torch.rand(B).to(float)),
    }

def reference(x, v, sigma):
    s = sigma.reshape(-1, 1, 1, 1)
    return x - s * v
```

```asm
; @launch grid=(256,1,1) block=(1024,1,1) lds=0
.amdgcn_target "amdgcn-amd-amdhsa--gfx950"
.text
.globl standalone__consistency_rf_step__diffusion_kernel
.p2align 8
.type standalone__consistency_rf_step__diffusion_kernel,@function
standalone__consistency_rf_step__diffusion_kernel:
    s_load_dwordx8 s[4:11], s[0:1], 0
    s_cmp_ge_u32 s2, 256
    s_cbranch_scc1 L_end
    s_bfe_u32 s3, s2, 0x20000
    s_lshl_b32 s3, s3, 14
    s_bfe_u32 s15, s2, 0x60002
    s_lshl_b32 s15, s15, 17
    s_or_b32 s3, s3, s15
    v_lshl_add_u32 v0, v0, 4, s3
    v_add_u32 v1, 65536, v0
    s_cmp_ge_u32 s3, 4194304
    s_cselect_b32 s13, 0, 16
    s_mov_b32 s14, 0xffff0000
    s_waitcnt lgkmcnt(0)
    global_load_dwordx4 v[8:11], v0, s[6:7] nt
    global_load_dwordx4 v[4:7], v0, s[4:5] nt
    s_load_dword s12, s[8:9], 0
    global_load_dwordx4 v[16:19], v1, s[6:7] nt
    global_load_dwordx4 v[12:15], v1, s[4:5] nt
    s_waitcnt lgkmcnt(0)
    s_lshl_b32 s12, s12, s13
    s_and_b32 s12, s12, s14
    s_waitcnt vmcnt(3)
    v_lshlrev_b32 v20, 16, v8
    v_and_b32 v21, s14, v8
    v_pk_mul_f32 v[20:21], v[20:21], s[12:13] op_sel_hi:[1,0]
    v_cvt_pk_bf16_f32 v8, v20, v21
    v_lshlrev_b32 v22, 16, v9
    v_and_b32 v23, s14, v9
    v_pk_mul_f32 v[22:23], v[22:23], s[12:13] op_sel_hi:[1,0]
    v_cvt_pk_bf16_f32 v9, v22, v23
    v_lshlrev_b32 v20, 16, v10
    v_and_b32 v21, s14, v10
    v_pk_mul_f32 v[20:21], v[20:21], s[12:13] op_sel_hi:[1,0]
    v_cvt_pk_bf16_f32 v10, v20, v21
    v_lshlrev_b32 v22, 16, v11
    v_and_b32 v23, s14, v11
    v_pk_mul_f32 v[22:23], v[22:23], s[12:13] op_sel_hi:[1,0]
    v_cvt_pk_bf16_f32 v11, v22, v23
    s_waitcnt vmcnt(2)
    v_lshlrev_b32 v20, 16, v8
    v_and_b32 v21, s14, v8
    v_lshlrev_b32 v22, 16, v4
    v_and_b32 v23, s14, v4
    v_pk_add_f32 v[20:21], v[22:23], v[20:21] neg_lo:[0,1] neg_hi:[0,1]
    v_cvt_pk_bf16_f32 v4, v20, v21
    v_lshlrev_b32 v20, 16, v9
    v_and_b32 v21, s14, v9
    v_lshlrev_b32 v22, 16, v5
    v_and_b32 v23, s14, v5
    v_pk_add_f32 v[20:21], v[22:23], v[20:21] neg_lo:[0,1] neg_hi:[0,1]
    v_cvt_pk_bf16_f32 v5, v20, v21
    v_lshlrev_b32 v20, 16, v10
    v_and_b32 v21, s14, v10
    v_lshlrev_b32 v22, 16, v6
    v_and_b32 v23, s14, v6
    v_pk_add_f32 v[20:21], v[22:23], v[20:21] neg_lo:[0,1] neg_hi:[0,1]
    v_cvt_pk_bf16_f32 v6, v20, v21
    v_lshlrev_b32 v20, 16, v11
    v_and_b32 v21, s14, v11
    v_lshlrev_b32 v22, 16, v7
    v_and_b32 v23, s14, v7
    v_pk_add_f32 v[20:21], v[22:23], v[20:21] neg_lo:[0,1] neg_hi:[0,1]
    v_cvt_pk_bf16_f32 v7, v20, v21
    s_waitcnt vmcnt(1)
    v_lshlrev_b32 v20, 16, v16
    v_and_b32 v21, s14, v16
    v_pk_mul_f32 v[20:21], v[20:21], s[12:13] op_sel_hi:[1,0]
    v_cvt_pk_bf16_f32 v16, v20, v21
    v_lshlrev_b32 v22, 16, v17
    v_and_b32 v23, s14, v17
    v_pk_mul_f32 v[22:23], v[22:23], s[12:13] op_sel_hi:[1,0]
    v_cvt_pk_bf16_f32 v17, v22, v23
    v_lshlrev_b32 v20, 16, v18
    v_and_b32 v21, s14, v18
    v_pk_mul_f32 v[20:21], v[20:21], s[12:13] op_sel_hi:[1,0]
    v_cvt_pk_bf16_f32 v18, v20, v21
    v_lshlrev_b32 v22, 16, v19
    v_and_b32 v23, s14, v19
    v_pk_mul_f32 v[22:23], v[22:23], s[12:13] op_sel_hi:[1,0]
    v_cvt_pk_bf16_f32 v19, v22, v23
    s_waitcnt vmcnt(0)
    v_lshlrev_b32 v20, 16, v16
    v_and_b32 v21, s14, v16
    v_lshlrev_b32 v22, 16, v12
    v_and_b32 v23, s14, v12
    v_pk_add_f32 v[20:21], v[22:23], v[20:21] neg_lo:[0,1] neg_hi:[0,1]
    v_cvt_pk_bf16_f32 v12, v20, v21
    v_lshlrev_b32 v20, 16, v17
    v_and_b32 v21, s14, v17
    v_lshlrev_b32 v22, 16, v13
    v_and_b32 v23, s14, v13
    v_pk_add_f32 v[20:21], v[22:23], v[20:21] neg_lo:[0,1] neg_hi:[0,1]
    v_cvt_pk_bf16_f32 v13, v20, v21
    v_lshlrev_b32 v20, 16, v18
    v_and_b32 v21, s14, v18
    v_lshlrev_b32 v22, 16, v14
    v_and_b32 v23, s14, v14
    v_pk_add_f32 v[20:21], v[22:23], v[20:21] neg_lo:[0,1] neg_hi:[0,1]
    v_cvt_pk_bf16_f32 v14, v20, v21
    v_lshlrev_b32 v20, 16, v19
    v_and_b32 v21, s14, v19
    v_lshlrev_b32 v22, 16, v15
    v_and_b32 v23, s14, v15
    v_pk_add_f32 v[20:21], v[22:23], v[20:21] neg_lo:[0,1] neg_hi:[0,1]
    v_cvt_pk_bf16_f32 v15, v20, v21
    s_barrier
    global_store_dwordx4 v0, v[4:7], s[10:11] nt
    global_store_dwordx4 v1, v[12:15], s[10:11] nt
L_end:
    s_endpgm
.section .rodata,"a"
.p2align 6
.amdhsa_kernel standalone__consistency_rf_step__diffusion_kernel
  .amdhsa_next_free_vgpr 24
  .amdhsa_next_free_sgpr 16
  .amdhsa_accum_offset 24
  .amdhsa_group_segment_fixed_size 0
  .amdhsa_kernarg_size 48
  .amdhsa_user_sgpr_count 2
  .amdhsa_user_sgpr_kernarg_segment_ptr 1
  .amdhsa_system_sgpr_workgroup_id_x 1
  .amdhsa_float_denorm_mode_32 3
.end_amdhsa_kernel
```

```asm
; @launch grid=(256,1,1) block=(1024,1,1) lds=0
.amdgcn_target "amdgcn-amd-amdhsa--gfx950"
.text
.globl standalone__consistency_rf_step__diffusion_kernel
.p2align 8
.type standalone__consistency_rf_step__diffusion_kernel,@function
standalone__consistency_rf_step__diffusion_kernel:
    s_load_dwordx8 s[4:11], s[0:1], 0
    s_cmpk_ge_u32 s2, 256
    s_cbranch_scc1 L_end
    s_bfe_u32 s3, s2, 0x10000
    s_lshl_b32 s3, s3, 14
    s_bfe_u32 s15, s2, 0x70001
    s_lshl_b32 s15, s15, 16
    s_or_b32 s3, s3, s15
    v_lshl_add_u32 v0, v0, 4, s3
    v_add_u32 v1, 32768, v0
    s_waitcnt lgkmcnt(0)
    global_load_dwordx4 v[8:11], v0, s[6:7] nt
    s_barrier
    global_load_dwordx4 v[4:7], v0, s[4:5] nt
    s_load_dword s12, s[8:9], 0
    global_load_dwordx4 v[16:19], v1, s[6:7] nt
    s_barrier
    global_load_dwordx4 v[12:15], v1, s[4:5] nt
    s_cmp_ge_u32 s3, 4194304
    s_cselect_b32 s13, 0, 16
    s_mov_b32 s14, 0xffff0000
    s_waitcnt lgkmcnt(0)
    s_lshl_b32 s12, s12, s13
    s_and_b32 s12, s12, s14
    s_waitcnt vmcnt(3)
    v_lshlrev_b32 v24, 16, v8
    v_and_b32 v25, s14, v8
    v_lshlrev_b32 v26, 16, v9
    v_and_b32 v27, s14, v9
    v_lshlrev_b32 v28, 16, v10
    v_and_b32 v29, s14, v10
    v_lshlrev_b32 v30, 16, v11
    v_and_b32 v31, s14, v11
    v_pk_mul_f32 v[24:25], v[24:25], s[12:13] op_sel_hi:[1,0]
    v_pk_mul_f32 v[26:27], v[26:27], s[12:13] op_sel_hi:[1,0]
    v_pk_mul_f32 v[28:29], v[28:29], s[12:13] op_sel_hi:[1,0]
    v_pk_mul_f32 v[30:31], v[30:31], s[12:13] op_sel_hi:[1,0]
    v_cvt_pk_bf16_f32 v24, 0, v24
    v_cvt_pk_bf16_f32 v25, 0, v25
    v_cvt_pk_bf16_f32 v26, 0, v26
    v_cvt_pk_bf16_f32 v27, 0, v27
    v_cvt_pk_bf16_f32 v28, 0, v28
    v_cvt_pk_bf16_f32 v29, 0, v29
    v_cvt_pk_bf16_f32 v30, 0, v30
    v_cvt_pk_bf16_f32 v31, 0, v31
    s_waitcnt vmcnt(2)
    v_lshlrev_b32 v8, 16, v4
    v_and_b32 v9, s14, v4
    v_lshlrev_b32 v10, 16, v5
    v_and_b32 v11, s14, v5
    v_lshlrev_b32 v20, 16, v6
    v_and_b32 v21, s14, v6
    v_lshlrev_b32 v22, 16, v7
    v_and_b32 v23, s14, v7
    v_pk_add_f32 v[8:9], v[8:9], v[24:25] neg_lo:[0,1] neg_hi:[0,1]
    v_pk_add_f32 v[10:11], v[10:11], v[26:27] neg_lo:[0,1] neg_hi:[0,1]
    v_pk_add_f32 v[20:21], v[20:21], v[28:29] neg_lo:[0,1] neg_hi:[0,1]
    v_pk_add_f32 v[22:23], v[22:23], v[30:31] neg_lo:[0,1] neg_hi:[0,1]
    v_cvt_pk_bf16_f32 v4, v8, v9
    v_cvt_pk_bf16_f32 v5, v10, v11
    v_cvt_pk_bf16_f32 v6, v20, v21
    v_cvt_pk_bf16_f32 v7, v22, v23
    s_waitcnt vmcnt(1)
    v_lshlrev_b32 v24, 16, v16
    v_and_b32 v25, s14, v16
    v_lshlrev_b32 v26, 16, v17
    v_and_b32 v27, s14, v17
    v_lshlrev_b32 v28, 16, v18
    v_and_b32 v29, s14, v18
    v_lshlrev_b32 v30, 16, v19
    v_and_b32 v31, s14, v19
    v_pk_mul_f32 v[24:25], v[24:25], s[12:13] op_sel_hi:[1,0]
    v_pk_mul_f32 v[26:27], v[26:27], s[12:13] op_sel_hi:[1,0]
    v_pk_mul_f32 v[28:29], v[28:29], s[12:13] op_sel_hi:[1,0]
    v_pk_mul_f32 v[30:31], v[30:31], s[12:13] op_sel_hi:[1,0]
    v_cvt_pk_bf16_f32 v24, 0, v24
    v_cvt_pk_bf16_f32 v25, 0, v25
    v_cvt_pk_bf16_f32 v26, 0, v26
    v_cvt_pk_bf16_f32 v27, 0, v27
    v_cvt_pk_bf16_f32 v28, 0, v28
    v_cvt_pk_bf16_f32 v29, 0, v29
    v_cvt_pk_bf16_f32 v30, 0, v30
    v_cvt_pk_bf16_f32 v31, 0, v31
    s_waitcnt vmcnt(0)
    s_barrier
    global_store_dwordx4 v0, v[4:7], s[10:11] nt
    v_lshlrev_b32 v16, 16, v12
    v_and_b32 v17, s14, v12
    v_lshlrev_b32 v18, 16, v13
    v_and_b32 v19, s14, v13
    v_lshlrev_b32 v20, 16, v14
    v_and_b32 v21, s14, v14
    v_lshlrev_b32 v22, 16, v15
    v_and_b32 v23, s14, v15
    v_pk_add_f32 v[16:17], v[16:17], v[24:25] neg_lo:[0,1] neg_hi:[0,1]
    v_pk_add_f32 v[18:19], v[18:19], v[26:27] neg_lo:[0,1] neg_hi:[0,1]
    v_pk_add_f32 v[20:21], v[20:21], v[28:29] neg_lo:[0,1] neg_hi:[0,1]
    v_pk_add_f32 v[22:23], v[22:23], v[30:31] neg_lo:[0,1] neg_hi:[0,1]
    v_cvt_pk_bf16_f32 v12, v16, v17
    v_cvt_pk_bf16_f32 v13, v18, v19
    v_cvt_pk_bf16_f32 v14, v20, v21
    v_cvt_pk_bf16_f32 v15, v22, v23
    global_store_dwordx4 v1, v[12:15], s[10:11] nt
L_end:
    s_endpgm
.section .rodata,"a"
.p2align 6
.amdhsa_kernel standalone__consistency_rf_step__diffusion_kernel
  .amdhsa_next_free_vgpr 32
  .amdhsa_next_free_sgpr 16
  .amdhsa_accum_offset 32
  .amdhsa_group_segment_fixed_size 0
  .amdhsa_kernarg_size 48
  .amdhsa_user_sgpr_count 2
  .amdhsa_user_sgpr_kernarg_segment_ptr 1
  .amdhsa_system_sgpr_workgroup_id_x 1
  .amdhsa_float_denorm_mode_32 3
.end_amdhsa_kernel
```
